```python
import torch

def _softmax(x, axis=-1):
    return torch.softmax(x, dim=axis)
def _gelu(x):
    return torch.nn.functional.gelu(x, approximate="tanh")
def _silu(x):
    return torch.nn.functional.silu(x)
def _sigmoid(x):
    return torch.sigmoid(x)
def _layernorm(x, axis=-1, eps=1e-5):
    m = x.mean(dim=axis, keepdim=True)
    v = x.var(dim=axis, keepdim=True, unbiased=False)
    return (x - m) / torch.sqrt(v + eps)
def _scatter_add(tgt, idx, src, axis=0):
    return tgt.clone().index_add_(axis, idx, src)
def _segment_sum(src, seg, n):
    out = torch.zeros((n,) + src.shape[1:], dtype=src.dtype)
    return out.index_add_(0, seg, src)
def _pad(x, pw):
    flat = tuple(v for pair in reversed(pw) for v in pair)
    return torch.nn.functional.pad(x, flat)

kernel_name = 'gather_scatter__edge_featured_mpnn_egc__graph'

def setup_inputs():

    _w = (lambda a: (lambda t: t.to(torch.bfloat16) if t.is_floating_point() else t)(torch.as_tensor(a)))
    N, deg, D, De = 12500, 64, 64, max(4, 1)
    E = N * deg
    return {
        "x": _w((lambda *s: torch.randn(*s, dtype=torch.bfloat16) * 0.2)(N, D)),
        "e_attr": _w((lambda *s: torch.randn(*s, dtype=torch.bfloat16) * 0.2)(E, De)),
        "src": _w((lambda lo, hi, *s: torch.randint(lo, hi, s))(0, N, E).to(torch.int64)),
        "dst": _w((lambda lo, hi, *s: torch.randint(lo, hi, s))(0, N, E).to(torch.int64)),
        "u_w": _w((lambda *s: torch.randn(*s, dtype=torch.bfloat16) * 0.05)(D, D)),
        "v_w": _w((lambda *s: torch.randn(*s, dtype=torch.bfloat16) * 0.05)(D, D)),
        "g_w": _w((lambda *s: torch.randn(*s, dtype=torch.bfloat16) * 0.2)(2 * D + De, D)),
    }

def reference(x, e_attr, src, dst, u_w, v_w, g_w):
    N, D = x.shape
    g_in = torch.concatenate([x[dst], x[src], e_attr], axis=-1)
    eta = _sigmoid(g_in @ g_w)
    hv = x @ v_w
    msg = eta * hv[src]
    agg = _segment_sum(msg, dst, N)
    return _silu(x @ u_w + agg)
```

```asm
; @launch grid=(256,1,1) block=(1024,1,1) lds=149120
.amdgcn_target "amdgcn-amd-amdhsa--gfx950"
.text
.globl gather_scatter__edge_featured_mpnn_egc__graph_kernel
.p2align 8
.type gather_scatter__edge_featured_mpnn_egc__graph_kernel,@function
gather_scatter__edge_featured_mpnn_egc__graph_kernel:
    s_cmp_ge_u32 s2, 256
    s_cbranch_scc1 L_end
    s_load_dwordx2 s[8:9], s[0:1], 24
    s_load_dwordx2 s[36:37], s[0:1], 72
    s_load_dwordx2 s[12:13], s[0:1], 16
    s_load_dwordx2 s[16:17], s[0:1], 8
    s_load_dwordx2 s[20:21], s[0:1], 0
    s_load_dwordx2 s[32:33], s[0:1], 48
    s_load_dwordx2 s[24:25], s[0:1], 40
    s_load_dwordx2 s[28:29], s[0:1], 32
    s_load_dwordx2 s[68:69], s[0:1], 56
    s_load_dwordx2 s[72:73], s[0:1], 64
    v_readfirstlane_b32 s3, v0
    v_and_b32 v1, 63, v0
    v_lshlrev_b32 v2, 2, v0
    v_mov_b64 v[40:41], 0
    v_mov_b64 v[42:43], 0
    ds_write_b32 v2, v40
    s_cmp_lt_u32 s2, 255
    s_movk_i32 s5, 784
    s_cselect_b32 s5, s5, 80
    v_cmp_gt_u32 s[44:45], s5, v0
    v_lshlrev_b32 v4, 4, v0
    v_lshlrev_b32 v7, 4, v1
    s_lshr_b32 s3, s3, 6
    v_cndmask_b32 v5, 2.0, v4, s[44:45]
    s_mul_i32 s6, s2, 12544
    s_lshl_b32 s7, s3, 10
    s_lshl_b32 s79, s2, 10
    s_add_u32 s79, s79, 4194304
    s_lshl_b32 s5, s7, 6
    s_add_u32 s5, s5, s79
    s_sub_u32 s5, s5, 786432
    s_mov_b32 s10, 3200000
    s_mov_b32 s11, 0x20000
    s_mov_b32 s38, 16777216
    s_mov_b32 s39, 0x20000
    s_mov_b32 s14, 3200000
    s_mov_b32 s15, 0x20000
    s_mov_b32 s18, 6400000
    s_mov_b32 s19, 0x20000
    s_mov_b32 s22, 1600000
    s_mov_b32 s23, 0x20000
    s_mov_b32 s34, 16896
    s_mov_b32 s35, 0x20000
    s_mov_b32 s26, 8192
    s_mov_b32 s27, 0x20000
    s_mov_b32 s30, 8192
    s_mov_b32 s31, 0x20000
    s_mov_b32 s70, 1600000
    s_mov_b32 s71, 0x20000
    s_mov_b32 s74, 256
    s_mov_b32 s75, 0x20000
    s_cmp_lt_u32 s3, 12
    s_cselect_b32 s42, 64, s2
    s_cmp_lt_u32 s42, 64
    s_waitcnt lgkmcnt(0)
    s_cbranch_scc0 L_noclr
    buffer_store_dwordx4 v[40:43], v7, s[36:39], s5 offen sc1
L_noclr:
    s_cmp_eq_u32 s3, 14
    s_cbranch_scc0 L_nowpf
    s_lshr_b32 s42, s2, 3
    s_lshl_b32 s42, s42, 8
    s_mul_i32 s43, s42, 3
    v_lshlrev_b32 v55, 7, v1
    s_mov_b64 exec, 3
    buffer_load_dword v54, v55, s[28:31], s42 offen
    buffer_load_dword v53, v55, s[24:27], s42 offen
    s_mov_b64 exec, 63
    buffer_load_dword v52, v55, s[32:35], s43 offen
    s_mov_b64 exec, -1
L_nowpf:
    buffer_load_dwordx4 v[8:11], v5, s[8:11], s6 offen
    s_and_b32 s4, s2, 7
    s_lshl_b32 s4, s4, 5
    s_lshr_b32 s5, s2, 3
    s_add_u32 s4, s4, s5
    s_mul_i32 s63, s4, 6272
    s_mov_b32 s64, s36
    s_or_b32 s65, s37, 2147483648
    s_mov_b32 s66, 4194304
    s_mov_b32 s67, 0xc00000
    s_add_u32 s42, s32, 8192
    s_addc_u32 s43, s33, 0
    s_cmp_lt_u32 s3, 8
    s_cselect_b32 s24, s42, s24
    s_cselect_b32 s25, s43, s25
    s_cselect_b32 s28, s32, s28
    s_cselect_b32 s29, s33, s29
    s_mov_b32 s5, 96512
    s_bfe_u32 s40, s3, 0x20001
    s_and_b32 s41, s3, 1
    v_and_b32 v31, 0x70, v0
    v_xor_b32 v31, v31, v7
    v_xor_b32 v31, 64, v31
    v_and_b32 v32, 16, v0
    v_and_b32 v33, 64, v0
    v_lshl_or_b32 v32, v32, 1, v33
    v_xor_b32 v47, v32, v7
    s_add_u32 m0, s7, 96512
    s_and_b32 s59, s7, 8191
    buffer_load_dwordx4 v47, s[24:27], s59 offen lds
    s_add_u32 m0, s7, 131712
    s_add_u32 s42, s63, s7
    s_sub_u32 s42, s42, 9216
    s_cmp_lt_u32 s3, 9
    s_cbranch_scc1 L_nox
    buffer_load_dwordx4 v31, s[20:23], s42 offen lds
L_nox:
    v_and_b32 v6, 15, v1
    v_lshrrev_b32 v126, 4, v1
    s_lshl_b32 s42, s40, 11
    s_add_u32 s42, s42, 140928
    v_lshrrev_b32 v2, 1, v6
    v_xor_b32 v2, v2, v126
    v_lshlrev_b32 v2, 4, v2
    v_lshl_add_u32 v124, v6, 7, v2
    v_add_u32 v124, s42, v124
    v_lshrrev_b32 v125, 2, v6
    v_lshl_add_u32 v125, v126, 3, v125
    v_bfe_u32 v2, v1, 3, 2
    v_xor_b32 v2, s41, v2
    v_lshl_add_u32 v125, v125, 2, v2
    v_and_b32 v2, 3, v1
    v_lshl_add_u32 v125, v125, 2, v2
    v_lshl_add_u32 v125, v125, 3, s5
    v_subrev_u32 v30, 3072, v4
    s_movk_i32 s43, 12544
    v_cmp_gt_u32 vcc, s43, v30
    v_lshlrev_b32 v28, 16, v0
    v_mov_b32 v3, 4
    v_cndmask_b32 v30, 2.0, v30, vcc
    v_lshlrev_b32 v2, 3, v0
    s_mov_b32 s52, -49
    s_movk_i32 s54, 0x4000
    s_mov_b32 s55, 0x8000
    s_mov_b32 s56, 0xc000
    s_mov_b32 s61, 0
    s_mov_b32 s62, 0
    s_mov_b32 s53, 0xbfb8aa3b
    s_movk_i32 s58, 0x61ff
    s_lshl_b32 s42, s6, 1
    s_add_u32 s42, s42, s7
    s_add_u32 m0, s7, 53504
    s_cmp_lt_u32 s3, 9
    s_barrier
    buffer_load_dwordx4 v[12:15], v5, s[12:15], s6 offen
    s_cbranch_scc0 L_w0
    s_waitcnt vmcnt(2)
L_w0:
    s_waitcnt vmcnt(3)
    s_mov_b64 exec, s[44:45]
    s_cbranch_execz L_norank
    v_mul_u32_u24 v24, 21400, v8
    v_lshrrev_b32 v24, 20, v24
    v_lshlrev_b32 v16, 2, v24
    ds_add_rtn_u32 v20, v16, v3 offset:512
    v_mul_u32_u24 v25, 21400, v9
    v_lshrrev_b32 v25, 20, v25
    v_lshlrev_b32 v17, 2, v25
    ds_add_rtn_u32 v21, v17, v3 offset:512
    v_mul_u32_u24 v26, 21400, v10
    v_lshrrev_b32 v26, 20, v26
    v_lshlrev_b32 v18, 2, v26
    ds_add_rtn_u32 v22, v18, v3 offset:512
    v_mul_u32_u24 v27, 21400, v11
    v_lshrrev_b32 v27, 20, v27
    v_lshlrev_b32 v19, 2, v27
    ds_add_rtn_u32 v23, v19, v3 offset:512
L_norank:
    s_mov_b64 exec, -1
    buffer_load_dwordx4 v7, s[16:19], s42 offen lds
    s_cmp_lt_u32 s3, 9
    s_cbranch_scc0 L_xldb
    s_add_u32 m0, s7, 69888
    s_add_u32 s42, s42, 16384
    buffer_load_dwordx4 v7, s[16:19], s42 offen lds
L_xldb:
    s_waitcnt lgkmcnt(0)
    s_barrier
    s_sub_u32 s43, s3, 13
    s_cmp_lt_u32 s43, 2
    s_cbranch_scc1 L_sig
    s_cmp_eq_u32 s3, 0
    s_cbranch_scc0 L_noscan
    ds_read_b128 v[32:35], v7 offset:512
    s_waitcnt lgkmcnt(0)
    v_add_u32 v44, v32, v33
    v_add_u32 v45, v44, v34
    v_add_u32 v46, v45, v35
    v_mov_b32 v36, v46
    s_nop 1
    v_add_u32_dpp v36, v36, v36 row_shr:1 row_mask:0xf bank_mask:0xf bound_ctrl:0
    s_nop 1
    v_add_u32_dpp v36, v36, v36 row_shr:2 row_mask:0xf bank_mask:0xf bound_ctrl:0
    s_nop 1
    v_add_u32_dpp v36, v36, v36 row_shr:4 row_mask:0xf bank_mask:0xf bound_ctrl:0
    s_nop 1
    v_add_u32_dpp v36, v36, v36 row_shr:8 row_mask:0xf bank_mask:0xf bound_ctrl:0
    s_nop 1
    v_add_u32_dpp v36, v36, v36 row_bcast:15 row_mask:0xa bank_mask:0xf
    s_nop 1
    v_add_u32_dpp v36, v36, v36 row_bcast:31 row_mask:0xc bank_mask:0xf
    v_sub_u32 v36, v36, v46
    v_add_u32 v36, 0x40000, v36
    v_add_u32 v37, v36, v32
    v_add_u32 v38, v36, v44
    v_add_u32 v39, v36, v45
    v_lshl_add_u32 v36, v32, 16, v36
    v_lshl_add_u32 v37, v33, 16, v37
    v_lshl_add_u32 v38, v34, 16, v38
    v_lshl_add_u32 v39, v35, 16, v39
    ds_write_b128 v7, v[36:39] offset:1536
L_noscan:
    v_mad_i32_i24 v24, v24, s52, v8
    v_lshl_or_b32 v24, v24, 26, v28
    v_mad_i32_i24 v25, v25, s52, v9
    v_lshl_or_b32 v25, v25, 26, v28
    v_mad_i32_i24 v26, v26, s52, v10
    v_lshl_or_b32 v26, v26, 26, v28
    v_mad_i32_i24 v27, v27, s52, v11
    v_lshl_or_b32 v27, v27, 26, v28
    s_waitcnt lgkmcnt(0)
    s_barrier
    s_mov_b64 exec, s[44:45]
    s_cbranch_execz L_nosc
    ds_read_u16 v16, v16 offset:1536
    ds_read_u16 v17, v17 offset:1536
    ds_read_u16 v18, v18 offset:1536
    ds_read_u16 v19, v19 offset:1536
    s_bitcmp1_b32 s58, s3
    s_cbranch_scc1 L_w1
    s_waitcnt vmcnt(1)
L_w1:
    s_waitcnt vmcnt(2)
    v_or_b32 v12, v12, v24
    v_or3_b32 v13, v13, v25, s54
    v_or3_b32 v14, v14, v26, s55
    v_or3_b32 v15, v15, v27, s56
    s_waitcnt lgkmcnt(3)
    v_add_u32 v16, v16, v20
    ds_write_b32 v16, v12 offset:40192
    s_waitcnt lgkmcnt(3)
    v_add_u32 v17, v17, v21
    ds_write_b32 v17, v13 offset:40192
    s_waitcnt lgkmcnt(3)
    v_add_u32 v18, v18, v22
    ds_write_b32 v18, v14 offset:40192
    s_waitcnt lgkmcnt(3)
    v_add_u32 v19, v19, v23
    ds_write_b32 v19, v15 offset:40192
L_nosc:
    s_mov_b64 exec, -1
    s_bitcmp1_b32 s58, s3
    s_cbranch_scc1 L_w2
    s_waitcnt vmcnt(1)
L_w2:
    s_waitcnt vmcnt(2)
    s_mul_i32 s42, s2, 25088
    s_add_u32 s42, s42, 9437184
    s_add_u32 s57, s6, 5242880
    s_add_u32 s5, s42, 16384
    s_waitcnt lgkmcnt(0)
    s_barrier
    s_cmp_lt_u32 s3, 8
    s_cbranch_scc1 L_nojob1
    v_xor_b32 v104, 64, v124
    v_xor_b32 v105, 64, v125
    ds_read_b128 v[64:67], v124
    ds_read_b128 v[68:71], v104
    ds_read_b64_tr_b16 v[72:73], v125 offset:0
    ds_read_b64_tr_b16 v[74:75], v125 offset:512
    ds_read_b64_tr_b16 v[76:77], v125 offset:4096
    ds_read_b64_tr_b16 v[78:79], v125 offset:4608
    ds_read_b64_tr_b16 v[80:81], v105 offset:0
    ds_read_b64_tr_b16 v[82:83], v105 offset:512
    ds_read_b64_tr_b16 v[84:85], v105 offset:4096
    ds_read_b64_tr_b16 v[86:87], v105 offset:4608
    ds_read_b64_tr_b16 v[88:89], v125 offset:8192
    ds_read_b64_tr_b16 v[90:91], v125 offset:8704
    ds_read_b64_tr_b16 v[92:93], v125 offset:12288
    ds_read_b64_tr_b16 v[94:95], v125 offset:12800
    ds_read_b64_tr_b16 v[96:97], v105 offset:8192
    ds_read_b64_tr_b16 v[98:99], v105 offset:8704
    ds_read_b64_tr_b16 v[100:101], v105 offset:12288
    ds_read_b64_tr_b16 v[102:103], v105 offset:12800
    s_waitcnt lgkmcnt(12)
    v_mfma_f32_16x16x32_bf16 v[104:107], v[64:67], v[72:75], 0
    v_mfma_f32_16x16x32_bf16 v[104:107], v[68:71], v[76:79], v[104:107]
    s_waitcnt lgkmcnt(8)
    v_mfma_f32_16x16x32_bf16 v[108:111], v[64:67], v[80:83], 0
    v_mfma_f32_16x16x32_bf16 v[108:111], v[68:71], v[84:87], v[108:111]
    s_waitcnt lgkmcnt(4)
    v_mfma_f32_16x16x32_bf16 v[112:115], v[64:67], v[88:91], 0
    v_mfma_f32_16x16x32_bf16 v[112:115], v[68:71], v[92:95], v[112:115]
    s_waitcnt lgkmcnt(0)
    v_mfma_f32_16x16x32_bf16 v[116:119], v[64:67], v[96:99], 0
    v_mfma_f32_16x16x32_bf16 v[116:119], v[68:71], v[100:103], v[116:119]
    s_lshl_b32 s46, s40, 12
    s_lshl_b32 s47, s41, 6
    s_add_u32 s46, s46, s47
    s_add_u32 s46, s46, 80128
    v_mov_b32 v29, 0x21800000
    v_lshlrev_b32 v24, 10, v126
    v_lshl_add_u32 v24, v6, 2, v24
    v_add_u32 v24, s46, v24
    v_fma_f32 v104, v104, s53, v29
    v_fma_f32 v105, v105, s53, v29
    v_fma_f32 v106, v106, s53, v29
    v_fma_f32 v107, v107, s53, v29
    v_fma_f32 v108, v108, s53, v29
    v_fma_f32 v109, v109, s53, v29
    v_fma_f32 v110, v110, s53, v29
    v_fma_f32 v111, v111, s53, v29
    v_cvt_pk_bf16_f32 v64, v112, v112
    v_cvt_pk_bf16_f32 v65, v113, v113
    v_cvt_pk_bf16_f32 v66, v114, v114
    v_cvt_pk_bf16_f32 v67, v115, v115
    v_add_f32 v116, 0, v116
    v_add_f32 v117, 0, v117
    v_add_f32 v118, 0, v118
    v_add_f32 v119, 0, v119
    v_sub_u32_sdwa v104, v104, v64 clamp dst_sel:DWORD dst_unused:UNUSED_PAD src0_sel:DWORD src1_sel:WORD_0
    v_sub_u32_sdwa v105, v105, v65 clamp dst_sel:DWORD dst_unused:UNUSED_PAD src0_sel:DWORD src1_sel:WORD_0
    v_sub_u32_sdwa v106, v106, v66 clamp dst_sel:DWORD dst_unused:UNUSED_PAD src0_sel:DWORD src1_sel:WORD_0
    v_sub_u32_sdwa v107, v107, v67 clamp dst_sel:DWORD dst_unused:UNUSED_PAD src0_sel:DWORD src1_sel:WORD_0
    v_cvt_pk_bf16_f32 v104, v112, v104
    v_cvt_pk_bf16_f32 v105, v113, v105
    v_cvt_pk_bf16_f32 v106, v114, v106
    v_cvt_pk_bf16_f32 v107, v115, v107
    v_sub_u32_sdwa v116, v116, v104 clamp dst_sel:DWORD dst_unused:UNUSED_PAD src0_sel:DWORD src1_sel:WORD_1
    v_sub_u32_sdwa v117, v117, v105 clamp dst_sel:DWORD dst_unused:UNUSED_PAD src0_sel:DWORD src1_sel:WORD_1
    v_sub_u32_sdwa v118, v118, v106 clamp dst_sel:DWORD dst_unused:UNUSED_PAD src0_sel:DWORD src1_sel:WORD_1
    v_sub_u32_sdwa v119, v119, v107 clamp dst_sel:DWORD dst_unused:UNUSED_PAD src0_sel:DWORD src1_sel:WORD_1
    v_cvt_pk_bf16_f32 v64, v116, v116
    v_cvt_pk_bf16_f32 v65, v117, v117
    v_cvt_pk_bf16_f32 v66, v118, v118
    v_cvt_pk_bf16_f32 v67, v119, v119
    v_sub_u32_sdwa v108, v108, v64 clamp dst_sel:DWORD dst_unused:UNUSED_PAD src0_sel:DWORD src1_sel:WORD_0
    v_sub_u32_sdwa v109, v109, v65 clamp dst_sel:DWORD dst_unused:UNUSED_PAD src0_sel:DWORD src1_sel:WORD_0
    v_sub_u32_sdwa v110, v110, v66 clamp dst_sel:DWORD dst_unused:UNUSED_PAD src0_sel:DWORD src1_sel:WORD_0
    v_sub_u32_sdwa v111, v111, v67 clamp dst_sel:DWORD dst_unused:UNUSED_PAD src0_sel:DWORD src1_sel:WORD_0
    v_cvt_pk_bf16_f32 v108, v116, v108
    ds_write2_b32 v24, v104, v108 offset0:0 offset1:32
    v_cvt_pk_bf16_f32 v109, v117, v109
    ds_write2_b32 v24, v105, v109 offset0:64 offset1:96
    v_cvt_pk_bf16_f32 v110, v118, v110
    ds_write2_b32 v24, v106, v110 offset0:128 offset1:160
    v_cvt_pk_bf16_f32 v111, v119, v111
    ds_write2_b32 v24, v107, v111 offset0:192 offset1:224
L_nojob1:
    ds_read_b128 v[20:23], v4 offset:37120
    ds_read_b64 v[8:9], v2 offset:40192
    ds_read_b64 v[10:11], v2 offset:48384
    v_cmp_gt_u32 vcc, 544, v0
    s_waitcnt lgkmcnt(2)
    buffer_store_dwordx4 v[20:23], v30, s[36:39], s57 offen sc1
    s_waitcnt lgkmcnt(0)
    v_lshrrev_b32 v8, 11, v8
    v_and_b32 v8, 0x7ff8, v8
    v_lshrrev_b32 v9, 11, v9
    v_and_b32 v9, 0x7ff8, v9
    v_lshrrev_b32 v10, 11, v10
    v_and_b32 v10, 0x7ff8, v10
    v_lshrrev_b32 v11, 11, v11
    v_and_b32 v11, 0x7ff8, v11
    v_add_u32 v31, 77056, v4
    s_lshl_b32 s43, s63, 1
    s_waitcnt vmcnt(1) lgkmcnt(0)
    s_barrier
    ds_read_b128 v[64:67], v31
    ds_read_b64 v[12:13], v8 offset:53504
    ds_read_b64 v[14:15], v9 offset:53504
    s_waitcnt lgkmcnt(2)
    buffer_store_dwordx4 v[64:67], v30, s[36:39], s43 offen sc1
    s_and_saveexec_b64 s[48:49], vcc
    s_cbranch_execz L_noe2
    ds_read_b64 v[16:17], v10 offset:53504
    ds_read_b64 v[18:19], v11 offset:53504
    s_waitcnt lgkmcnt(0)
    buffer_store_dwordx4 v[16:19], v4, s[36:39], s5 offen sc1
L_noe2:
    s_mov_b64 exec, -1
    s_waitcnt lgkmcnt(0)
    buffer_store_dwordx4 v[12:15], v4, s[36:39], s42 offen sc1
    s_add_u32 m0, s7, 124544
    s_nop 0
    buffer_load_dwordx4 v47, s[28:31], s59 offen lds
    v_lshlrev_b32 v9, 1, v1
    v_add_u32 v9, 148096, v9
    ds_read_u16 v32, v9 offset:0
    ds_read_u16 v33, v9 offset:128
    ds_read_u16 v34, v9 offset:256
    ds_read_u16 v35, v9 offset:384
    v_lshrrev_b32 v24, 5, v1
    v_bfe_u32 v25, v1, 2, 1
    v_and_b32 v26, 1, v1
    v_and_b32 v52, 31, v1
    v_cmp_eq_u32 vcc, v25, v24
    v_mov_b32 v27, 0x3f803f80
    v_lshrrev_b32 v28, 3, v52
    v_cndmask_b32 v27, 0, v27, vcc
    v_cmp_eq_u32 vcc, 0, v26
    v_bfe_u32 v29, v1, 1, 1
    v_lshl_add_u32 v28, v28, 1, v29
    v_cndmask_b32 v58, 0, v27, vcc
    v_cndmask_b32 v59, v27, 0, vcc
    v_cmp_eq_u32 vcc, v26, v24
    v_lshlrev_b32 v28, 3, v28
    v_add_u32 v28, 72704, v28
    v_mov_b32 v29, 124448
    v_cndmask_b32 v51, v29, v28, vcc
    v_cndmask_b32 v50, 0, 2, vcc
    v_lshlrev_b32 v52, 3, v52
    s_add_u32 s7, s3, 4
    s_and_b32 s7, s7, 15
    s_lshl_b32 s5, s7, 4
    s_add_u32 s5, s5, 40192
    v_lshl_add_u32 v120, v24, 3, s5
    v_lshl_add_u32 v121, v25, 3, s5
    s_mul_i32 s5, s7, 1056
    v_mul_u32_u24 v122, 528, v24
    v_add_u32 v122, s5, v122
    s_and_b32 s43, s3, 7
    s_lshr_b32 s5, s3, 3
    s_lshl_b32 s5, s5, 7
    s_add_u32 s43, s43, s5
    s_lshl_b32 s5, s43, 10
    s_lshl_b32 s42, s4, 2
    s_add_u32 s5, s5, s42
    s_add_u32 s5, s5, 4194304
    v_lshl_add_u32 v53, v126, 13, s5
    s_mov_b32 s76, 0x8000
    s_mov_b32 s77, 0x10000
    s_mov_b32 s78, 0x18000
    s_mul_i32 s5, s43, 12544
    s_add_u32 s80, s5, 5242880
    s_lshl_b32 s5, s5, 1
    s_add_u32 s84, s5, 9437184
    s_add_u32 s81, s80, 401408
    s_add_u32 s85, s84, 802816
    s_add_u32 s82, s80, 802816
    s_add_u32 s86, s84, 1605632
    s_add_u32 s83, s80, 1204224
    s_add_u32 s87, s84, 2408448
    s_lshr_b32 s5, s2, 3
    s_lshl_b32 s5, s5, 4
    s_add_u32 s5, s5, s3
    s_mul_i32 s88, s5, 6272
    v_lshlrev_b32 v54, 7, v1
    s_and_b32 s24, s2, 0xf8
    s_lshr_b32 s25, s3, 1
    s_add_u32 s24, s24, s25
    s_mul_i32 s24, s24, 12544
    s_and_b32 s25, s2, 7
    s_mul_i32 s25, s25, 1574
    s_add_u32 s24, s24, s25
    s_mul_i32 s25, s41, 896
    s_add_u32 s24, s24, s25
    s_add_u32 s24, s24, 5242880
    s_andn2_b32 s24, s24, 127
    s_waitcnt lgkmcnt(0)
    v_lshlrev_b32 v32, 16, v32
    v_mul_f32 v32, s53, v32
    v_lshlrev_b32 v33, 16, v33
    v_mul_f32 v33, s53, v33
    v_lshlrev_b32 v34, 16, v34
    v_mul_f32 v34, s53, v34
    v_lshlrev_b32 v35, 16, v35
    v_mul_f32 v35, s53, v35
    v_cvt_pk_bf16_f32 v60, v32, v33
    v_cvt_pk_bf16_f32 v61, v34, v35
    s_cmp_eq_u32 s3, 0
    s_cbranch_scc0 L_not
    v_lshlrev_b32 v24, 2, v1
L_dbg:
    buffer_load_dword v25, v24, s[72:75], 0 offen sc1
    s_add_u32 s62, s62, 1
    s_bitcmp1_b32 s62, 21
    s_cbranch_scc1 L_abort
    s_waitcnt vmcnt(0)
    v_cmp_eq_u32 vcc, 0, v25
    s_cbranch_vccnz L_dbg
L_not:
    s_waitcnt vmcnt(0)
    s_barrier
    s_cmp_eq_u32 s3, 0
    s_cbranch_scc0 L_not2
    buffer_store_dwordx4 v[36:39], v7, s[36:39], s79 offen sc1
L_not2:
    s_mov_b64 exec, 0x7f
    buffer_load_dword v55, v54, s[36:39], s24 offen sc1
    s_mov_b64 exec, -1
L_job:
    s_cmp_lt_u32 s3, 8
    s_cbranch_scc1 L_job2d
    v_xor_b32 v104, 64, v124
    v_xor_b32 v105, 64, v125
    ds_read_b128 v[64:67], v124
    ds_read_b128 v[68:71], v104
    ds_read_b64_tr_b16 v[72:73], v125 offset:28032
    ds_read_b64_tr_b16 v[74:75], v125 offset:28544
    ds_read_b64_tr_b16 v[76:77], v125 offset:32128
    ds_read_b64_tr_b16 v[78:79], v125 offset:32640
    ds_read_b64_tr_b16 v[80:81], v105 offset:28032
    ds_read_b64_tr_b16 v[82:83], v105 offset:28544
    ds_read_b64_tr_b16 v[84:85], v105 offset:32128
    ds_read_b64_tr_b16 v[86:87], v105 offset:32640
    ds_read_b64_tr_b16 v[88:89], v125 offset:36224
    ds_read_b64_tr_b16 v[90:91], v125 offset:36736
    ds_read_b64_tr_b16 v[92:93], v125 offset:40320
    ds_read_b64_tr_b16 v[94:95], v125 offset:40832
    ds_read_b64_tr_b16 v[96:97], v105 offset:36224
    ds_read_b64_tr_b16 v[98:99], v105 offset:36736
    ds_read_b64_tr_b16 v[100:101], v105 offset:40320
    ds_read_b64_tr_b16 v[102:103], v105 offset:40832
    s_waitcnt lgkmcnt(12)
    v_mfma_f32_16x16x32_bf16 v[104:107], v[64:67], v[72:75], 0
    v_mfma_f32_16x16x32_bf16 v[104:107], v[68:71], v[76:79], v[104:107]
    s_waitcnt lgkmcnt(8)
    v_mfma_f32_16x16x32_bf16 v[108:111], v[64:67], v[80:83], 0
    v_mfma_f32_16x16x32_bf16 v[108:111], v[68:71], v[84:87], v[108:111]
    s_waitcnt lgkmcnt(4)
    v_mfma_f32_16x16x32_bf16 v[112:115], v[64:67], v[88:91], 0
    v_mfma_f32_16x16x32_bf16 v[112:115], v[68:71], v[92:95], v[112:115]
    s_waitcnt lgkmcnt(0)
    v_mfma_f32_16x16x32_bf16 v[116:119], v[64:67], v[96:99], 0
    v_mfma_f32_16x16x32_bf16 v[116:119], v[68:71], v[100:103], v[116:119]
    s_nop 1
    s_mul_i32 s42, s40, 12288
    s_lshl_b32 s43, s41, 7
    s_add_u32 s42, s42, s43
    v_mul_u32_u24 v8, 3072, v126
    v_lshl_add_u32 v8, v6, 3, v8
    v_add_u32 v8, s42, v8
    s_cmp_eq_u32 s40, 3
    s_cselect_b64 exec, 0xffff, -1
    v_mul_f32 v104, s53, v104
    v_mul_f32 v108, s53, v108
    v_and_b32 v64, 0xffff0000, v104
    v_and_b32 v65, 0xffff0000, v108
    v_sub_f32 v104, v104, v64
    v_sub_f32 v108, v108, v65
    v_cvt_pk_bf16_f32 v64, v64, v104
    v_cvt_pk_bf16_f32 v65, v65, v108
    v_cvt_f64_f32 v[66:67], v112
    v_cvt_f64_f32 v[68:69], v116
    ds_write_b64 v8, v[64:65] offset:2560
    ds_write_b64 v8, v[66:67] offset:2816
    ds_write_b64 v8, v[68:69] offset:3072
    s_cbranch_scc1 L_job2d
    v_mul_f32 v105, s53, v105
    v_mul_f32 v109, s53, v109
    v_and_b32 v72, 0xffff0000, v105
    v_and_b32 v73, 0xffff0000, v109
    v_sub_f32 v105, v105, v72
    v_sub_f32 v109, v109, v73
    v_cvt_pk_bf16_f32 v72, v72, v105
    v_cvt_pk_bf16_f32 v73, v73, v109
    v_cvt_f64_f32 v[74:75], v113
    v_cvt_f64_f32 v[76:77], v117
    ds_write_b64 v8, v[72:73] offset:3328
    ds_write_b64 v8, v[74:75] offset:3584
    ds_write_b64 v8, v[76:77] offset:3840
    v_mul_f32 v106, s53, v106
    v_mul_f32 v110, s53, v110
    v_and_b32 v80, 0xffff0000, v106
    v_and_b32 v81, 0xffff0000, v110
    v_sub_f32 v106, v106, v80
    v_sub_f32 v110, v110, v81
    v_cvt_pk_bf16_f32 v80, v80, v106
    v_cvt_pk_bf16_f32 v81, v81, v110
    v_cvt_f64_f32 v[82:83], v114
    v_cvt_f64_f32 v[84:85], v118
    ds_write_b64 v8, v[80:81] offset:4096
    ds_write_b64 v8, v[82:83] offset:4352
    ds_write_b64 v8, v[84:85] offset:4608
    v_mul_f32 v107, s53, v107
    v_mul_f32 v111, s53, v111
    v_and_b32 v88, 0xffff0000, v107
    v_and_b32 v89, 0xffff0000, v111
    v_sub_f32 v107, v107, v88
    v_sub_f32 v111, v111, v89
    v_cvt_pk_bf16_f32 v88, v88, v107
    v_cvt_pk_bf16_f32 v89, v89, v111
    v_cvt_f64_f32 v[90:91], v115
    v_cvt_f64_f32 v[92:93], v119
    ds_write_b64 v8, v[88:89] offset:4864
    ds_write_b64 v8, v[90:91] offset:5120
    ds_write_b64 v8, v[92:93] offset:5376
L_job2d:
    s_mov_b64 exec, -1
    s_mov_b32 s60, 0
    v_mov_b32 v8, 25872
    v_mov_b32 v9, 2560
    v_lshlrev_b32 v10, 3, v0
    v_cmp_gt_u32 vcc, 800, v0
    s_and_saveexec_b64 s[42:43], vcc
    ds_write_b64 v10, v[8:9] offset:40192
    v_cmp_gt_u32 vcc, 8, v0
    s_and_b64 exec, exec, vcc
    s_cbranch_execz L_noduma
    v_mul_u32_u24 v8, 528, v0
    v_mul_u32_u24 v9, 768, v0
    v_add_u32 v9, 2560, v9
    ds_write_b64 v10, v[8:9] offset:40192
    v_mov_b32 v8, 64
    ds_write_b32 v8, v8 offset:192
    v_mov_b32 v8, 100000
    v_lshlrev_b32 v9, 2, v0
    v_add_u32 v9, 72464, v9
    ds_write_b32 v9, v8
    v_mov_b64 v[8:9], 0
    v_add_u32 v10, 124448, v10
    ds_write_b64 v10, v[8:9]
L_noduma:
    s_mov_b64 exec, -1
    v_mov_b32 v8, 4
    v_mov_b32 v9, 0xfc
    s_lshl_b32 s5, s60, 18
    s_add_u32 s5, s5, 8912896
    s_mov_b32 s43, 72704
    s_movk_i32 s42, 0x200
    s_movk_i32 s89, 132
    v_add_u32 v22, s60, v6
    v_lshlrev_b32 v20, 18, v22
    v_add_u32 v20, 524288, v20
    v_add_u32 v21, 4194304, v20
    v_mul_u32_u24 v23, 25088, v126
    v_add_lshl_u32 v22, v22, v23, 2
    v_lshlrev_b32 v10, 2, v1
    s_lshl_b32 s6, s3, 5
    v_mul_u32_u24 v31, 528, v1
    v_add_u32 v116, s6, v31
    v_mul_u32_u24 v117, 768, v1
    v_add_u32 v117, 2560, v117
    v_mov_b32 v48, v120
    v_mov_b32 v49, v121
    ds_read_b32 v11, v8 offset:264
    s_waitcnt lgkmcnt(0)
    v_cmp_ne_u32 vcc, 0, v11
    s_cbranch_vccnz L_end
L_poll:
    buffer_load_dword v2, v53, s[36:39], 0 offen sc1
    buffer_load_dword v3, v53, s[36:39], s76 offen sc1
    buffer_load_dword v4, v53, s[36:39], s77 offen sc1
    buffer_load_dword v5, v53, s[36:39], s78 offen sc1
    s_add_u32 s62, s62, 1
    s_bitcmp1_b32 s62, 21
    s_waitcnt vmcnt(0)
    v_min_u32 v11, v2, v3
    v_min3_u32 v11, v11, v4, v5
    v_cmp_eq_u32 vcc, 0, v11
    s_cbranch_vccnz L_repoll
L_window:
    v_cmp_le_u32 s[44:45], v20, v2
    v_cmp_le_u32 s[52:53], v21, v2
    v_cmp_le_u32 s[46:47], v20, v3
    v_cmp_le_u32 s[54:55], v21, v3
    v_cmp_le_u32 s[48:49], v20, v4
    v_cmp_le_u32 s[56:57], v21, v4
    v_cmp_le_u32 s[50:51], v20, v5
    v_cmp_le_u32 s[58:59], v21, v5
L_round:
    v_add_u32_sdwa v12, v22, v2 dst_sel:DWORD dst_unused:UNUSED_PAD src0_sel:DWORD src1_sel:WORD_0
    v_lshlrev_b32 v16, 1, v12
    v_add_u32_sdwa v13, v22, v3 dst_sel:DWORD dst_unused:UNUSED_PAD src0_sel:DWORD src1_sel:WORD_0
    v_lshlrev_b32 v17, 1, v13
    v_add_u32_sdwa v14, v22, v4 dst_sel:DWORD dst_unused:UNUSED_PAD src0_sel:DWORD src1_sel:WORD_0
    v_lshlrev_b32 v18, 1, v14
    v_add_u32_sdwa v15, v22, v5 dst_sel:DWORD dst_unused:UNUSED_PAD src0_sel:DWORD src1_sel:WORD_0
    v_lshlrev_b32 v19, 1, v15
    s_mov_b64 exec, s[52:53]
    s_cbranch_execz L_n2_0
    buffer_load_dword v68, v12, s[36:39], s80 offen offset:64 sc1
    buffer_load_dwordx2 v[88:89], v16, s[36:39], s84 offen offset:128 sc1
L_n2_0:
    s_mov_b64 exec, s[54:55]
    s_cbranch_execz L_n2_1
    buffer_load_dword v69, v13, s[36:39], s81 offen offset:64 sc1
    buffer_load_dwordx2 v[90:91], v17, s[36:39], s85 offen offset:128 sc1
L_n2_1:
    s_mov_b64 exec, s[56:57]
    s_cbranch_execz L_n2_2
    buffer_load_dword v70, v14, s[36:39], s82 offen offset:64 sc1
    buffer_load_dwordx2 v[92:93], v18, s[36:39], s86 offen offset:128 sc1
L_n2_2:
    s_mov_b64 exec, s[58:59]
    s_cbranch_execz L_n2_3
    buffer_load_dword v71, v15, s[36:39], s83 offen offset:64 sc1
    buffer_load_dwordx2 v[94:95], v19, s[36:39], s87 offen offset:128 sc1
L_n2_3:
    s_or_b64 exec, s[44:45], 1
    buffer_load_dword v64, v12, s[36:39], s80 offen sc1
    s_or_b64 exec, s[46:47], 1
    buffer_load_dword v65, v13, s[36:39], s81 offen sc1
    s_or_b64 exec, s[48:49], 1
    buffer_load_dword v66, v14, s[36:39], s82 offen sc1
    s_or_b64 exec, s[50:51], 1
    buffer_load_dword v67, v15, s[36:39], s83 offen sc1
    s_or_b64 exec, s[44:45], 1
    buffer_load_dwordx2 v[80:81], v16, s[36:39], s84 offen sc1
    s_or_b64 exec, s[46:47], 1
    buffer_load_dwordx2 v[82:83], v17, s[36:39], s85 offen sc1
    s_or_b64 exec, s[48:49], 1
    buffer_load_dwordx2 v[84:85], v18, s[36:39], s86 offen sc1
    s_or_b64 exec, s[50:51], 1
    buffer_load_dwordx2 v[86:87], v19, s[36:39], s87 offen sc1
    s_mov_b64 exec, -1
    v_max_u32 v11, v2, v3
    v_max3_u32 v11, v11, v4, v5
    v_cmp_le_u32 s[90:91], s5, v11
    s_mov_b64 exec, s[44:45]
    s_waitcnt vmcnt(7)
    v_and_b32_sdwa v96, v64, v9 dst_sel:DWORD dst_unused:UNUSED_PAD src0_sel:BYTE_3 src1_sel:DWORD
    ds_add_rtn_u32 v72, v96, v8 offset:0
    v_lshlrev_b32 v64, 18, v64
    v_lshrrev_b32 v64, 15, v64
    s_mov_b64 exec, s[46:47]
    s_waitcnt vmcnt(6)
    v_and_b32_sdwa v97, v65, v9 dst_sel:DWORD dst_unused:UNUSED_PAD src0_sel:BYTE_3 src1_sel:DWORD
    ds_add_rtn_u32 v73, v97, v8 offset:0
    v_lshlrev_b32 v65, 18, v65
    v_lshrrev_b32 v65, 15, v65
    s_mov_b64 exec, s[48:49]
    s_waitcnt vmcnt(5)
    v_and_b32_sdwa v98, v66, v9 dst_sel:DWORD dst_unused:UNUSED_PAD src0_sel:BYTE_3 src1_sel:DWORD
    ds_add_rtn_u32 v74, v98, v8 offset:0
    v_lshlrev_b32 v66, 18, v66
    v_lshrrev_b32 v66, 15, v66
    s_mov_b64 exec, s[50:51]
    s_waitcnt vmcnt(4)
    v_and_b32_sdwa v99, v67, v9 dst_sel:DWORD dst_unused:UNUSED_PAD src0_sel:BYTE_3 src1_sel:DWORD
    ds_add_rtn_u32 v75, v99, v8 offset:0
    v_lshlrev_b32 v67, 18, v67
    v_lshrrev_b32 v67, 15, v67
    s_mov_b64 exec, s[52:53]
    s_cbranch_execz L_r2_0
    v_and_b32_sdwa v100, v68, v9 dst_sel:DWORD dst_unused:UNUSED_PAD src0_sel:BYTE_3 src1_sel:DWORD
    ds_add_rtn_u32 v76, v100, v8 offset:0
    v_lshlrev_b32 v68, 18, v68
    v_lshrrev_b32 v68, 15, v68
L_r2_0:
    s_mov_b64 exec, s[54:55]
    s_cbranch_execz L_r2_1
    v_and_b32_sdwa v101, v69, v9 dst_sel:DWORD dst_unused:UNUSED_PAD src0_sel:BYTE_3 src1_sel:DWORD
    ds_add_rtn_u32 v77, v101, v8 offset:0
    v_lshlrev_b32 v69, 18, v69
    v_lshrrev_b32 v69, 15, v69
L_r2_1:
    s_mov_b64 exec, s[56:57]
    s_cbranch_execz L_r2_2
    v_and_b32_sdwa v102, v70, v9 dst_sel:DWORD dst_unused:UNUSED_PAD src0_sel:BYTE_3 src1_sel:DWORD
    ds_add_rtn_u32 v78, v102, v8 offset:0
    v_lshlrev_b32 v70, 18, v70
    v_lshrrev_b32 v70, 15, v70
L_r2_2:
    s_mov_b64 exec, s[58:59]
    s_cbranch_execz L_r2_3
    v_and_b32_sdwa v103, v71, v9 dst_sel:DWORD dst_unused:UNUSED_PAD src0_sel:BYTE_3 src1_sel:DWORD
    ds_add_rtn_u32 v79, v103, v8 offset:0
    v_lshlrev_b32 v71, 18, v71
    v_lshrrev_b32 v71, 15, v71
L_r2_3:
    s_waitcnt lgkmcnt(0)
    s_mov_b64 exec, s[52:53]
    s_cbranch_execz L_p2_0
    v_cmpx_gt_u32 vcc, s42, v76
    v_mad_u32_u24 v76, v100, s89, v76
    s_andn2_b64 s[52:53], s[52:53], exec
    ds_write_b32 v76, v68 offset:46592
    v_lshl_add_u32 v100, v76, 1, s43
    s_or_b64 s[90:91], s[90:91], s[52:53]
    ds_write_b64 v100, v[88:89]
L_p2_0:
    s_mov_b64 exec, s[54:55]
    s_cbranch_execz L_p2_1
    v_cmpx_gt_u32 vcc, s42, v77
    v_mad_u32_u24 v77, v101, s89, v77
    s_andn2_b64 s[54:55], s[54:55], exec
    ds_write_b32 v77, v69 offset:46592
    v_lshl_add_u32 v101, v77, 1, s43
    s_or_b64 s[90:91], s[90:91], s[54:55]
    ds_write_b64 v101, v[90:91]
L_p2_1:
    s_mov_b64 exec, s[56:57]
    s_cbranch_execz L_p2_2
    v_cmpx_gt_u32 vcc, s42, v78
    v_mad_u32_u24 v78, v102, s89, v78
    s_andn2_b64 s[56:57], s[56:57], exec
    ds_write_b32 v78, v70 offset:46592
    v_lshl_add_u32 v102, v78, 1, s43
    s_or_b64 s[90:91], s[90:91], s[56:57]
    ds_write_b64 v102, v[92:93]
L_p2_2:
    s_mov_b64 exec, s[58:59]
    s_cbranch_execz L_p2_3
    v_cmpx_gt_u32 vcc, s42, v79
    v_mad_u32_u24 v79, v103, s89, v79
    s_andn2_b64 s[58:59], s[58:59], exec
    ds_write_b32 v79, v71 offset:46592
    v_lshl_add_u32 v103, v79, 1, s43
    s_or_b64 s[90:91], s[90:91], s[58:59]
    ds_write_b64 v103, v[94:95]
L_p2_3:
    s_mov_b64 exec, s[44:45]
    v_cmpx_gt_u32 vcc, s42, v72
    v_mad_u32_u24 v72, v96, s89, v72
    s_andn2_b64 s[44:45], s[44:45], exec
    ds_write_b32 v72, v64 offset:46592
    v_lshl_add_u32 v96, v72, 1, s43
    s_or_b64 s[90:91], s[90:91], s[44:45]
    s_waitcnt vmcnt(3)
    ds_write_b64 v96, v[80:81]
    s_mov_b64 exec, s[46:47]
    v_cmpx_gt_u32 vcc, s42, v73
    v_mad_u32_u24 v73, v97, s89, v73
    s_andn2_b64 s[46:47], s[46:47], exec
    ds_write_b32 v73, v65 offset:46592
    v_lshl_add_u32 v97, v73, 1, s43
    s_or_b64 s[90:91], s[90:91], s[46:47]
    s_waitcnt vmcnt(2)
    ds_write_b64 v97, v[82:83]
    s_mov_b64 exec, s[48:49]
    v_cmpx_gt_u32 vcc, s42, v74
    v_mad_u32_u24 v74, v98, s89, v74
    s_andn2_b64 s[48:49], s[48:49], exec
    ds_write_b32 v74, v66 offset:46592
    v_lshl_add_u32 v98, v74, 1, s43
    s_or_b64 s[90:91], s[90:91], s[48:49]
    s_waitcnt vmcnt(1)
    ds_write_b64 v98, v[84:85]
    s_mov_b64 exec, s[50:51]
    v_cmpx_gt_u32 vcc, s42, v75
    v_mad_u32_u24 v75, v99, s89, v75
    s_andn2_b64 s[50:51], s[50:51], exec
    ds_write_b32 v75, v67 offset:46592
    v_lshl_add_u32 v99, v75, 1, s43
    s_or_b64 s[90:91], s[90:91], s[50:51]
    s_waitcnt vmcnt(0)
    ds_write_b64 v99, v[86:87]
    s_mov_b64 exec, -1
    s_cbranch_scc0 L_nomore
    ds_write_b32 v8, v8 offset:256
L_nomore:
    s_mov_b32 exec_lo, 0x3ffff
    s_mov_b32 exec_hi, 0x0
    buffer_load_dword v55, v54, s[36:39], s88 offen sc1
    s_mov_b64 exec, -1
    s_waitcnt lgkmcnt(0)
    s_barrier
    ds_read_b32 v11, v10 offset:0
    s_cmp_ge_u32 s3, 12
    s_cbranch_scc1 L_early
    s_mov_b32 s40, 0
    s_waitcnt lgkmcnt(0)
L_earlyb:
    v_min_u32 v11, s42, v11
    v_cmp_lt_u32 vcc, s6, v11
    s_cmp_eq_u32 s3, 0
    s_cselect_b32 s5, 0xff, 0
    s_andn2_b32 vcc_lo, vcc_lo, s5
    s_bcnt1_i32_b64 s6, vcc
    s_cbranch_scc0 L_nolev
    s_lshl_b32 s6, s6, 3
    v_mov_b32 v14, s6
    s_mov_b64 exec, 1
    ds_add_rtn_u32 v14, v10, v14 offset:256
    s_mov_b64 exec, -1
    v_mbcnt_lo_u32_b32 v15, vcc_lo, 0
    v_mbcnt_hi_u32_b32 v15, vcc_hi, v15
    s_waitcnt lgkmcnt(0)
    v_readfirstlane_b32 s6, v14
    s_mov_b64 exec, vcc
    s_nop 0
    v_lshl_add_u32 v15, v15, 3, s6
    ds_write_b64 v15, v[116:117] offset:40192
    s_mov_b64 exec, -1
L_nolev:
    s_sub_u32 s6, s3, 4
    s_cmp_lt_u32 s6, 8
    s_cbranch_scc0 L_nopad
    s_lshl_b32 s6, s6, 2
    v_add_u32 v14, 28, v11
    v_and_b32 v14, 0xffffffe0, v14
    s_mov_b64 exec, 0xff
    v_max_u32 v14, 32, v14
    s_mov_b64 exec, -1
    v_add_u32 v11, s6, v11
    v_cmpx_lt_u32 vcc, v11, v14
    v_add_u32 v11, v31, v11
    v_mov_b32 v14, 100000
    ds_write_b32 v11, v14 offset:46592
    v_lshl_add_u32 v11, v11, 1, s43
    v_mov_b64 v[14:15], 0
    ds_write_b64 v11, v[14:15]
    s_mov_b64 exec, -1
L_nopad:
    v_mov_b32 v10, 0
    s_waitcnt lgkmcnt(0)
    s_barrier
    ds_read_b64 v[8:9], v48
    ds_read_b32 v11, v10 offset:256
    ds_read_b32 v13, v49
    ds_read_b64 v[26:27], v48 offset:256
    ds_read_b32 v28, v49 offset:256
    v_mov_b64 v[14:15], 0
    s_cmp_eq_u32 s40, 0
    s_cbranch_scc0 L_nog0
    s_waitcnt lgkmcnt(4)
    ds_read_b128 v[16:19], v8 offset:46592
    ds_read_b128 v[20:23], v8 offset:46608
    s_waitcnt lgkmcnt(0)
    buffer_load_dword v64, v16, s[64:67], 0 offen
    buffer_load_dword v65, v16, s[64:67], 0 offen offset:4
    buffer_load_dword v66, v17, s[64:67], 0 offen
    buffer_load_dword v67, v17, s[64:67], 0 offen offset:4
    buffer_load_dword v68, v18, s[64:67], 0 offen
    buffer_load_dword v69, v18, s[64:67], 0 offen offset:4
    buffer_load_dword v70, v19, s[64:67], 0 offen
    buffer_load_dword v71, v19, s[64:67], 0 offen offset:4
    buffer_load_dword v72, v20, s[64:67], 0 offen
    buffer_load_dword v73, v20, s[64:67], 0 offen offset:4
    buffer_load_dword v74, v21, s[64:67], 0 offen
    buffer_load_dword v75, v21, s[64:67], 0 offen offset:4
    buffer_load_dword v76, v22, s[64:67], 0 offen
    buffer_load_dword v77, v22, s[64:67], 0 offen offset:4
    buffer_load_dword v78, v23, s[64:67], 0 offen
    buffer_load_dword v79, v23, s[64:67], 0 offen offset:4
L_nog0:
    s_waitcnt lgkmcnt(0)
    v_readfirstlane_b32 s41, v11
    v_add_u32 v24, v9, v52
    v_mad_u32_u24 v29, v13, v50, v51
    ds_read_b64 v[62:63], v24
    ds_read_b64 v[56:57], v29
    ds_read_b128 v[16:19], v26 offset:46592
    ds_read_b128 v[20:23], v26 offset:46608
    s_add_u32 s41, s41, 248
    s_lshr_b32 s41, s41, 4
    s_sub_u32 s41, s41, s7
    s_lshr_b32 s41, s41, 4
    s_cbranch_scc0 L_mdone
    s_cmp_eq_u32 s61, 0
    s_cbranch_scc0 L_slow
    s_cmp_lt_u32 s41, 2
    s_waitcnt lgkmcnt(0)
    s_cbranch_scc1 L_tail0
L_fast:
    s_setprio 3
    s_waitcnt vmcnt(0) lgkmcnt(2)
    v_mfma_f32_32x32x16_bf16 v[96:111], v[56:59], v[60:63], v[64:79]
    v_lshlrev_b64 v[32:33], 16, v[64:65]
    v_lshlrev_b64 v[34:35], 16, v[66:67]
    v_lshlrev_b64 v[36:37], 16, v[68:69]
    v_lshlrev_b64 v[38:39], 16, v[70:71]
    v_lshlrev_b64 v[40:41], 16, v[72:73]
    v_lshlrev_b64 v[42:43], 16, v[74:75]
    v_lshlrev_b64 v[44:45], 16, v[76:77]
    v_lshlrev_b64 v[46:47], 16, v[78:79]
    v_add_u32 v25, v27, v52
    v_mad_u32_u24 v29, v28, v50, v51
    s_setprio 2
    s_cmp_le_u32 s41, 4
    s_cbranch_scc1 L_bo0
L_bob0:
    buffer_load_dword v64, v16, s[64:67], 0 offen
    buffer_load_dword v65, v16, s[64:67], 0 offen offset:4
    buffer_load_dword v66, v17, s[64:67], 0 offen
    buffer_load_dword v67, v17, s[64:67], 0 offen offset:4
    buffer_load_dword v68, v18, s[64:67], 0 offen
    buffer_load_dword v69, v18, s[64:67], 0 offen offset:4
    buffer_load_dword v70, v19, s[64:67], 0 offen
    buffer_load_dword v71, v19, s[64:67], 0 offen offset:4
    buffer_load_dword v72, v20, s[64:67], 0 offen
    buffer_load_dword v73, v20, s[64:67], 0 offen offset:4
    buffer_load_dword v74, v21, s[64:67], 0 offen
    buffer_load_dword v75, v21, s[64:67], 0 offen offset:4
    buffer_load_dword v76, v22, s[64:67], 0 offen
    buffer_load_dword v77, v22, s[64:67], 0 offen offset:4
    buffer_load_dword v78, v23, s[64:67], 0 offen
    buffer_load_dword v79, v23, s[64:67], 0 offen offset:4
    ds_read_b64 v[62:63], v25
    ds_read_b64 v[56:57], v29
    ds_read_b64 v[26:27], v48 offset:512
    ds_read_b32 v28, v49 offset:512
    v_exp_f32 v96, v96
    v_exp_f32 v97, v97
    v_exp_f32 v98, v98
    v_exp_f32 v99, v99
    v_pk_add_f32 v[8:9], v[96:97], 1.0 op_sel_hi:[1,0]
    v_exp_f32 v100, v100
    v_exp_f32 v101, v101
    v_pk_fma_f32 v[10:11], v[32:33], v[98:99], v[32:33]
    v_pk_fma_f32 v[10:11], v[34:35], v[8:9], v[10:11]
    v_pk_fma_f32 v[8:9], v[8:9], v[98:99], v[8:9]
    s_waitcnt lgkmcnt(1)
    ds_read_b128 v[16:19], v26 offset:46592
    ds_read_b128 v[20:23], v26 offset:46608
    v_exp_f32 v102, v102
    v_exp_f32 v103, v103
    v_pk_fma_f32 v[10:11], v[10:11], v[100:101], v[10:11]
    v_pk_fma_f32 v[10:11], v[36:37], v[8:9], v[10:11]
    v_pk_fma_f32 v[8:9], v[8:9], v[100:101], v[8:9]
    v_exp_f32 v104, v104
    v_exp_f32 v105, v105
    v_pk_fma_f32 v[10:11], v[10:11], v[102:103], v[10:11]
    v_pk_fma_f32 v[10:11], v[38:39], v[8:9], v[10:11]
    v_pk_fma_f32 v[8:9], v[8:9], v[102:103], v[8:9]
    v_exp_f32 v106, v106
    v_exp_f32 v107, v107
    v_pk_fma_f32 v[10:11], v[10:11], v[104:105], v[10:11]
    v_pk_fma_f32 v[10:11], v[40:41], v[8:9], v[10:11]
    v_pk_fma_f32 v[8:9], v[8:9], v[104:105], v[8:9]
    v_exp_f32 v108, v108
    v_exp_f32 v109, v109
    v_pk_fma_f32 v[10:11], v[10:11], v[106:107], v[10:11]
    v_pk_fma_f32 v[10:11], v[42:43], v[8:9], v[10:11]
    v_pk_fma_f32 v[8:9], v[8:9], v[106:107], v[8:9]
    v_exp_f32 v110, v110
    v_exp_f32 v111, v111
    v_pk_fma_f32 v[10:11], v[10:11], v[108:109], v[10:11]
    v_pk_fma_f32 v[10:11], v[44:45], v[8:9], v[10:11]
    v_pk_fma_f32 v[8:9], v[8:9], v[108:109], v[8:9]
    v_pk_fma_f32 v[10:11], v[10:11], v[110:111], v[10:11]
    v_pk_fma_f32 v[10:11], v[46:47], v[8:9], v[10:11]
    v_pk_fma_f32 v[8:9], v[8:9], v[110:111], v[8:9]
    v_rcp_f32 v12, v8
    v_rcp_f32 v13, v9
    v_pk_add_f32 v[14:15], v[14:15], v[8:9]
    v_pk_mul_f32 v[10:11], v[10:11], v[12:13]
    s_sub_u32 s41, s41, 1
    s_cmp_lt_u32 s41, 2
    v_cvt_f64_f32 v[112:113], v10
    v_cvt_f64_f32 v[114:115], v11
    ds_add_f64 v24, v[112:113] offset:256
    ds_add_f64 v24, v[114:115] offset:512
    s_cbranch_scc1 L_tail1
    s_setprio 3
    s_waitcnt vmcnt(0) lgkmcnt(2)
    v_mfma_f32_32x32x16_bf16 v[96:111], v[56:59], v[60:63], v[64:79]
    v_lshlrev_b64 v[32:33], 16, v[64:65]
    v_lshlrev_b64 v[34:35], 16, v[66:67]
    v_lshlrev_b64 v[36:37], 16, v[68:69]
    v_lshlrev_b64 v[38:39], 16, v[70:71]
    v_lshlrev_b64 v[40:41], 16, v[72:73]
    v_lshlrev_b64 v[42:43], 16, v[74:75]
    v_lshlrev_b64 v[44:45], 16, v[76:77]
    v_lshlrev_b64 v[46:47], 16, v[78:79]
    v_add_u32 v24, v27, v52
    v_mad_u32_u24 v29, v28, v50, v51
    s_setprio 2
    s_cmp_le_u32 s41, 4
    s_cbranch_scc1 L_bo1
L_bob1:
    buffer_load_dword v64, v16, s[64:67], 0 offen
    buffer_load_dword v65, v16, s[64:67], 0 offen offset:4
    buffer_load_dword v66, v17, s[64:67], 0 offen
    buffer_load_dword v67, v17, s[64:67], 0 offen offset:4
    buffer_load_dword v68, v18, s[64:67], 0 offen
    buffer_load_dword v69, v18, s[64:67], 0 offen offset:4
    buffer_load_dword v70, v19, s[64:67], 0 offen
    buffer_load_dword v71, v19, s[64:67], 0 offen offset:4
    buffer_load_dword v72, v20, s[64:67], 0 offen
    buffer_load_dword v73, v20, s[64:67], 0 offen offset:4
    buffer_load_dword v74, v21, s[64:67], 0 offen
    buffer_load_dword v75, v21, s[64:67], 0 offen offset:4
    buffer_load_dword v76, v22, s[64:67], 0 offen
    buffer_load_dword v77, v22, s[64:67], 0 offen offset:4
    buffer_load_dword v78, v23, s[64:67], 0 offen
    buffer_load_dword v79, v23, s[64:67], 0 offen offset:4
    ds_read_b64 v[62:63], v24
    ds_read_b64 v[56:57], v29
    ds_read_b64 v[26:27], v48 offset:768
    ds_read_b32 v28, v49 offset:768
    v_add_u32 v48, 512, v48
    v_add_u32 v49, 512, v49
    v_exp_f32 v96, v96
    v_exp_f32 v97, v97
    v_exp_f32 v98, v98
    v_exp_f32 v99, v99
    v_pk_add_f32 v[8:9], v[96:97], 1.0 op_sel_hi:[1,0]
    v_exp_f32 v100, v100
    v_exp_f32 v101, v101
    v_pk_fma_f32 v[10:11], v[32:33], v[98:99], v[32:33]
    v_pk_fma_f32 v[10:11], v[34:35], v[8:9], v[10:11]
    v_pk_fma_f32 v[8:9], v[8:9], v[98:99], v[8:9]
    s_waitcnt lgkmcnt(1)
    ds_read_b128 v[16:19], v26 offset:46592
    ds_read_b128 v[20:23], v26 offset:46608
    v_exp_f32 v102, v102
    v_exp_f32 v103, v103
    v_pk_fma_f32 v[10:11], v[10:11], v[100:101], v[10:11]
    v_pk_fma_f32 v[10:11], v[36:37], v[8:9], v[10:11]
    v_pk_fma_f32 v[8:9], v[8:9], v[100:101], v[8:9]
    v_exp_f32 v104, v104
    v_exp_f32 v105, v105
    v_pk_fma_f32 v[10:11], v[10:11], v[102:103], v[10:11]
    v_pk_fma_f32 v[10:11], v[38:39], v[8:9], v[10:11]
    v_pk_fma_f32 v[8:9], v[8:9], v[102:103], v[8:9]
    v_exp_f32 v106, v106
    v_exp_f32 v107, v107
    v_pk_fma_f32 v[10:11], v[10:11], v[104:105], v[10:11]
    v_pk_fma_f32 v[10:11], v[40:41], v[8:9], v[10:11]
    v_pk_fma_f32 v[8:9], v[8:9], v[104:105], v[8:9]
    v_exp_f32 v108, v108
    v_exp_f32 v109, v109
    v_pk_fma_f32 v[10:11], v[10:11], v[106:107], v[10:11]
    v_pk_fma_f32 v[10:11], v[42:43], v[8:9], v[10:11]
    v_pk_fma_f32 v[8:9], v[8:9], v[106:107], v[8:9]
    v_exp_f32 v110, v110
    v_exp_f32 v111, v111
    v_pk_fma_f32 v[10:11], v[10:11], v[108:109], v[10:11]
    v_pk_fma_f32 v[10:11], v[44:45], v[8:9], v[10:11]
    v_pk_fma_f32 v[8:9], v[8:9], v[108:109], v[8:9]
    v_pk_fma_f32 v[10:11], v[10:11], v[110:111], v[10:11]
    v_pk_fma_f32 v[10:11], v[46:47], v[8:9], v[10:11]
    v_pk_fma_f32 v[8:9], v[8:9], v[110:111], v[8:9]
    v_rcp_f32 v12, v8
    v_rcp_f32 v13, v9
    v_pk_add_f32 v[14:15], v[14:15], v[8:9]
    v_pk_mul_f32 v[10:11], v[10:11], v[12:13]
    s_sub_u32 s41, s41, 1
    s_cmp_lt_u32 s41, 2
    v_cvt_f64_f32 v[112:113], v10
    v_cvt_f64_f32 v[114:115], v11
    ds_add_f64 v25, v[112:113] offset:256
    ds_add_f64 v25, v[114:115] offset:512
    s_cbranch_scc0 L_fast
    s_branch L_tail0
L_tail1:
    v_mov_b32 v24, v25
L_tail0:
    s_setprio 3
    s_waitcnt vmcnt(0) lgkmcnt(2)
    v_mfma_f32_32x32x16_bf16 v[96:111], v[56:59], v[60:63], v[64:79]
    v_lshlrev_b64 v[32:33], 16, v[64:65]
    v_lshlrev_b64 v[34:35], 16, v[66:67]
    v_lshlrev_b64 v[36:37], 16, v[68:69]
    v_lshlrev_b64 v[38:39], 16, v[70:71]
    v_lshlrev_b64 v[40:41], 16, v[72:73]
    v_lshlrev_b64 v[42:43], 16, v[74:75]
    v_lshlrev_b64 v[44:45], 16, v[76:77]
    v_lshlrev_b64 v[46:47], 16, v[78:79]
    s_nop 2
    s_setprio 0
    v_exp_f32 v96, v96
    v_exp_f32 v97, v97
    v_exp_f32 v98, v98
    v_exp_f32 v99, v99
    v_pk_add_f32 v[8:9], v[96:97], 1.0 op_sel_hi:[1,0]
    v_exp_f32 v100, v100
    v_exp_f32 v101, v101
    v_pk_fma_f32 v[10:11], v[32:33], v[98:99], v[32:33]
    v_pk_fma_f32 v[10:11], v[34:35], v[8:9], v[10:11]
    v_pk_fma_f32 v[8:9], v[8:9], v[98:99], v[8:9]
    v_exp_f32 v102, v102
    v_exp_f32 v103, v103
    v_pk_fma_f32 v[10:11], v[10:11], v[100:101], v[10:11]
    v_pk_fma_f32 v[10:11], v[36:37], v[8:9], v[10:11]
    v_pk_fma_f32 v[8:9], v[8:9], v[100:101], v[8:9]
    v_exp_f32 v104, v104
    v_exp_f32 v105, v105
    v_pk_fma_f32 v[10:11], v[10:11], v[102:103], v[10:11]
    v_pk_fma_f32 v[10:11], v[38:39], v[8:9], v[10:11]
    v_pk_fma_f32 v[8:9], v[8:9], v[102:103], v[8:9]
    v_exp_f32 v106, v106
    v_exp_f32 v107, v107
    v_pk_fma_f32 v[10:11], v[10:11], v[104:105], v[10:11]
    v_pk_fma_f32 v[10:11], v[40:41], v[8:9], v[10:11]
    v_pk_fma_f32 v[8:9], v[8:9], v[104:105], v[8:9]
    v_exp_f32 v108, v108
    v_exp_f32 v109, v109
    v_pk_fma_f32 v[10:11], v[10:11], v[106:107], v[10:11]
    v_pk_fma_f32 v[10:11], v[42:43], v[8:9], v[10:11]
    v_pk_fma_f32 v[8:9], v[8:9], v[106:107], v[8:9]
    v_exp_f32 v110, v110
    v_exp_f32 v111, v111
    v_pk_fma_f32 v[10:11], v[10:11], v[108:109], v[10:11]
    v_pk_fma_f32 v[10:11], v[44:45], v[8:9], v[10:11]
    v_pk_fma_f32 v[8:9], v[8:9], v[108:109], v[8:9]
    v_pk_fma_f32 v[10:11], v[10:11], v[110:111], v[10:11]
    v_pk_fma_f32 v[10:11], v[46:47], v[8:9], v[10:11]
    v_pk_fma_f32 v[8:9], v[8:9], v[110:111], v[8:9]
    v_rcp_f32 v12, v8
    v_rcp_f32 v13, v9
    v_pk_add_f32 v[14:15], v[14:15], v[8:9]
    v_pk_mul_f32 v[10:11], v[10:11], v[12:13]
    v_cvt_f64_f32 v[112:113], v10
    v_cvt_f64_f32 v[114:115], v11
    ds_add_f64 v24, v[112:113] offset:256
    ds_add_f64 v24, v[114:115] offset:512
L_mdone:
    v_add_f32 v14, v14, v15
    s_waitcnt vmcnt(0) lgkmcnt(0)
    v_mov_b32 v16, 260
    ds_read_b32 v17, v16
    v_cmp_ngt_f32 vcc, 0x7e000000, v14
    s_cbranch_vccz L_sok
    ds_write_b32 v16, v16 offset:4
L_sok:
    v_lshrrev_b32 v8, 4, v0
    v_mul_u32_u24 v9, 768, v8
    v_lshl_add_u32 v9, v6, 5, v9
    v_lshlrev_b32 v10, 3, v0
    s_waitcnt lgkmcnt(0)
    v_readfirstlane_b32 s5, v17
    s_barrier
    s_cmp_eq_u32 s5, 0
    s_cbranch_scc0 L_again
    v_cmp_gt_u32 vcc, 784, v0
    s_and_saveexec_b64 s[46:47], vcc
    s_cbranch_execz L_noout
    ds_read_b128 v[32:35], v9 offset:2816
    ds_read_b128 v[36:39], v9 offset:2832
    s_waitcnt lgkmcnt(0)
    v_cvt_f32_f64 v24, v[32:33]
    v_cvt_f32_f64 v25, v[34:35]
    v_cvt_f32_f64 v26, v[36:37]
    v_cvt_f32_f64 v27, v[38:39]
    v_mul_f32 v28, 0xbfb8aa3b, v24
    v_mul_f32 v29, 0xbfb8aa3b, v25
    v_mul_f32 v30, 0xbfb8aa3b, v26
    v_mul_f32 v31, 0xbfb8aa3b, v27
    v_exp_f32 v28, v28
    v_exp_f32 v29, v29
    v_exp_f32 v30, v30
    v_exp_f32 v31, v31
    v_pk_add_f32 v[18:19], v[24:25], v[26:27]
    v_pk_add_f32 v[28:29], v[28:29], 1.0 op_sel_hi:[1,0]
    v_pk_add_f32 v[30:31], v[30:31], 1.0 op_sel_hi:[1,0]
    v_rcp_f32 v28, v28
    v_rcp_f32 v29, v29
    v_rcp_f32 v30, v30
    v_rcp_f32 v31, v31
    v_add_f32 v18, v18, v19
    v_pk_mul_f32 v[28:29], v[28:29], v[24:25]
    v_pk_mul_f32 v[30:31], v[30:31], v[26:27]
    v_cvt_pk_bf16_f32 v28, v28, v29
    v_cvt_pk_bf16_f32 v29, v30, v31
    buffer_store_dwordx2 v[28:29], v10, s[68:71], s63 offen
    v_mov_b32 v19, 0x207
    v_cmp_class_f32 vcc, v18, v19
    s_cbranch_vccz L_noout
    ds_write_b32 v16, v16 offset:4
L_noout:
    s_mov_b64 exec, -1
    s_cmp_eq_u32 s61, 0
    s_cbranch_scc0 L_fin
    s_waitcnt lgkmcnt(0)
    s_barrier
    ds_read_b32 v17, v16 offset:4
    s_waitcnt lgkmcnt(0)
    v_readfirstlane_b32 s5, v17
    s_cmp_eq_u32 s5, 0
    s_cbranch_scc0 L_redo
L_fin:
L_end:
    s_endpgm
L_sig:
    s_cmp_eq_u32 s3, 14
    s_cbranch_scc1 L_cld
    s_lshl_b32 s43, s2, 2
    v_lshl_add_u32 v32, v1, 10, s43
    buffer_store_dword v3, v32, s[72:75], 0 offen sc1
    s_branch L_noscan
L_cld:
    s_mov_b32 m0, 148096
    s_nop 0
    buffer_load_dwordx4 v7, s[32:35], s54 offen lds
    s_branch L_noscan
L_repoll:
    s_cbranch_scc0 L_poll
    s_branch L_window
L_early:
    ds_read_b128 v[16:19], v122 offset:46592
    ds_read_b128 v[20:23], v122 offset:46608
    s_waitcnt lgkmcnt(2)
    v_cmp_gt_u32 vcc, 32, v11
    s_and_b32 s40, vcc_lo, 0xff
    s_cselect_b32 s40, 0, 1
    s_waitcnt lgkmcnt(0)
    s_cbranch_scc1 L_earlyb
    buffer_load_dword v64, v16, s[64:67], 0 offen
    buffer_load_dword v65, v16, s[64:67], 0 offen offset:4
    buffer_load_dword v66, v17, s[64:67], 0 offen
    buffer_load_dword v67, v17, s[64:67], 0 offen offset:4
    buffer_load_dword v68, v18, s[64:67], 0 offen
    buffer_load_dword v69, v18, s[64:67], 0 offen offset:4
    buffer_load_dword v70, v19, s[64:67], 0 offen
    buffer_load_dword v71, v19, s[64:67], 0 offen offset:4
    buffer_load_dword v72, v20, s[64:67], 0 offen
    buffer_load_dword v73, v20, s[64:67], 0 offen offset:4
    buffer_load_dword v74, v21, s[64:67], 0 offen
    buffer_load_dword v75, v21, s[64:67], 0 offen offset:4
    buffer_load_dword v76, v22, s[64:67], 0 offen
    buffer_load_dword v77, v22, s[64:67], 0 offen offset:4
    buffer_load_dword v78, v23, s[64:67], 0 offen
    buffer_load_dword v79, v23, s[64:67], 0 offen offset:4
    s_branch L_earlyb
L_bo0:
    s_setprio 1
    s_cmp_gt_u32 s41, 1
    s_cbranch_scc1 L_bob0
    s_setprio 0
    s_branch L_bob0
L_bo1:
    s_setprio 1
    s_cmp_gt_u32 s41, 1
    s_cbranch_scc1 L_bob1
    s_setprio 0
    s_branch L_bob1
L_abort:
    s_waitcnt vmcnt(0)
    v_mov_b32 v25, 268
    ds_write_b32 v25, v25
    s_waitcnt lgkmcnt(0)
    s_endpgm
L_redo:
    s_mov_b32 s61, 1
    s_mov_b32 s53, 0xbfb8aa3b
    s_bfe_u32 s40, s3, 0x20001
    s_and_b32 s41, s3, 1
    v_lshlrev_b32 v10, 2, v1
    v_mov_b32 v11, 0
    ds_write_b32 v10, v11 offset:0
    s_waitcnt vmcnt(0) lgkmcnt(0)
    s_barrier
    s_branch L_job
L_again:
    v_lshlrev_b32 v10, 2, v1
    v_mov_b32 v12, 0
    ds_write_b32 v10, v12 offset:0
    ds_write_b32 v12, v12 offset:260
    s_or_b64 s[90:91], s[44:45], s[46:47]
    s_or_b64 s[90:91], s[90:91], s[48:49]
    s_or_b64 s[90:91], s[90:91], s[50:51]
    s_or_b64 s[90:91], s[90:91], s[52:53]
    s_or_b64 s[90:91], s[90:91], s[54:55]
    s_or_b64 s[90:91], s[90:91], s[56:57]
    s_or_b64 s[90:91], s[90:91], s[58:59]
    s_cselect_b32 s40, 0, 32
    s_add_u32 s60, s60, s40
    s_min_u32 s60, s60, 3136
    v_mov_b32 v8, 25872
    v_mov_b32 v9, 2560
    v_lshlrev_b32 v10, 3, v0
    v_cmp_gt_u32 vcc, 800, v0
    s_and_saveexec_b64 s[42:43], vcc
    ds_write_b64 v10, v[8:9] offset:40192
    v_cmp_gt_u32 vcc, 8, v0
    s_and_b64 exec, exec, vcc
    s_cbranch_execz L_nodumb
    v_mul_u32_u24 v8, 528, v0
    v_mul_u32_u24 v9, 768, v0
    v_add_u32 v9, 2560, v9
    ds_write_b64 v10, v[8:9] offset:40192
    v_mov_b32 v8, 64
    ds_write_b32 v8, v8 offset:192
    v_mov_b32 v8, 100000
    v_lshlrev_b32 v9, 2, v0
    v_add_u32 v9, 72464, v9
    ds_write_b32 v9, v8
    v_mov_b64 v[8:9], 0
    v_add_u32 v10, 124448, v10
    ds_write_b64 v10, v[8:9]
L_nodumb:
    s_mov_b64 exec, -1
    v_mov_b32 v8, 4
    v_mov_b32 v9, 0xfc
    s_lshl_b32 s5, s60, 18
    s_add_u32 s5, s5, 8912896
    s_mov_b32 s43, 72704
    s_movk_i32 s42, 0x200
    s_movk_i32 s89, 132
    v_add_u32 v22, s60, v6
    v_lshlrev_b32 v20, 18, v22
    v_add_u32 v20, 524288, v20
    v_add_u32 v21, 4194304, v20
    v_mul_u32_u24 v23, 25088, v126
    v_add_lshl_u32 v22, v22, v23, 2
    v_lshlrev_b32 v10, 2, v1
    s_lshl_b32 s6, s3, 5
    v_mul_u32_u24 v31, 528, v1
    v_add_u32 v116, s6, v31
    v_mul_u32_u24 v117, 768, v1
    v_add_u32 v117, 2560, v117
    v_mov_b32 v48, v120
    v_mov_b32 v49, v121
    s_cmp_eq_u32 s40, 0
    s_waitcnt lgkmcnt(0)
    s_barrier
    s_cbranch_scc1 L_round
    s_branch L_window
L_slow:
    s_waitcnt vmcnt(0)
    ds_read_b64 v[8:9], v48
    ds_read_b32 v28, v49
    s_waitcnt lgkmcnt(0)
    ds_read_b128 v[16:19], v8 offset:46592
    ds_read_b128 v[20:23], v8 offset:46608
    v_add_u32 v24, v9, v52
    v_mad_u32_u24 v29, v28, v50, v51
    ds_read_b64 v[62:63], v24
    ds_read_b64 v[56:57], v29
    v_add_u32 v48, 256, v48
    v_add_u32 v49, 256, v49
    s_waitcnt lgkmcnt(0)
    buffer_load_dword v64, v16, s[64:67], 0 offen
    buffer_load_dword v65, v16, s[64:67], 0 offen offset:4
    buffer_load_dword v66, v17, s[64:67], 0 offen
    buffer_load_dword v67, v17, s[64:67], 0 offen offset:4
    buffer_load_dword v68, v18, s[64:67], 0 offen
    buffer_load_dword v69, v18, s[64:67], 0 offen offset:4
    buffer_load_dword v70, v19, s[64:67], 0 offen
    buffer_load_dword v71, v19, s[64:67], 0 offen offset:4
    buffer_load_dword v72, v20, s[64:67], 0 offen
    buffer_load_dword v73, v20, s[64:67], 0 offen offset:4
    buffer_load_dword v74, v21, s[64:67], 0 offen
    buffer_load_dword v75, v21, s[64:67], 0 offen offset:4
    buffer_load_dword v76, v22, s[64:67], 0 offen
    buffer_load_dword v77, v22, s[64:67], 0 offen offset:4
    buffer_load_dword v78, v23, s[64:67], 0 offen
    buffer_load_dword v79, v23, s[64:67], 0 offen offset:4
    s_waitcnt vmcnt(0)
    v_mfma_f32_32x32x16_bf16 v[96:111], v[56:59], v[60:63], v[64:79]
    v_lshlrev_b64 v[32:33], 16, v[64:65]
    v_lshlrev_b64 v[34:35], 16, v[66:67]
    v_lshlrev_b64 v[36:37], 16, v[68:69]
    v_lshlrev_b64 v[38:39], 16, v[70:71]
    v_lshlrev_b64 v[40:41], 16, v[72:73]
    v_lshlrev_b64 v[42:43], 16, v[74:75]
    v_lshlrev_b64 v[44:45], 16, v[76:77]
    v_lshlrev_b64 v[46:47], 16, v[78:79]
    s_nop 3
    v_mov_b64 v[10:11], 0
    v_exp_f32 v96, v96
    v_exp_f32 v97, v97
    s_nop 0
    v_pk_add_f32 v[96:97], v[96:97], 1.0 op_sel_hi:[1,0]
    v_rcp_f32 v96, v96
    v_rcp_f32 v97, v97
    s_nop 0
    v_pk_fma_f32 v[10:11], v[32:33], v[96:97], v[10:11]
    v_exp_f32 v98, v98
    v_exp_f32 v99, v99
    s_nop 0
    v_pk_add_f32 v[98:99], v[98:99], 1.0 op_sel_hi:[1,0]
    v_rcp_f32 v98, v98
    v_rcp_f32 v99, v99
    s_nop 0
    v_pk_fma_f32 v[10:11], v[34:35], v[98:99], v[10:11]
    v_exp_f32 v100, v100
    v_exp_f32 v101, v101
    s_nop 0
    v_pk_add_f32 v[100:101], v[100:101], 1.0 op_sel_hi:[1,0]
    v_rcp_f32 v100, v100
    v_rcp_f32 v101, v101
    s_nop 0
    v_pk_fma_f32 v[10:11], v[36:37], v[100:101], v[10:11]
    v_exp_f32 v102, v102
    v_exp_f32 v103, v103
    s_nop 0
    v_pk_add_f32 v[102:103], v[102:103], 1.0 op_sel_hi:[1,0]
    v_rcp_f32 v102, v102
    v_rcp_f32 v103, v103
    s_nop 0
    v_pk_fma_f32 v[10:11], v[38:39], v[102:103], v[10:11]
    v_exp_f32 v104, v104
    v_exp_f32 v105, v105
    s_nop 0
    v_pk_add_f32 v[104:105], v[104:105], 1.0 op_sel_hi:[1,0]
    v_rcp_f32 v104, v104
    v_rcp_f32 v105, v105
    s_nop 0
    v_pk_fma_f32 v[10:11], v[40:41], v[104:105], v[10:11]
    v_exp_f32 v106, v106
    v_exp_f32 v107, v107
    s_nop 0
    v_pk_add_f32 v[106:107], v[106:107], 1.0 op_sel_hi:[1,0]
    v_rcp_f32 v106, v106
    v_rcp_f32 v107, v107
    s_nop 0
    v_pk_fma_f32 v[10:11], v[42:43], v[106:107], v[10:11]
    v_exp_f32 v108, v108
    v_exp_f32 v109, v109
    s_nop 0
    v_pk_add_f32 v[108:109], v[108:109], 1.0 op_sel_hi:[1,0]
    v_rcp_f32 v108, v108
    v_rcp_f32 v109, v109
    s_nop 0
    v_pk_fma_f32 v[10:11], v[44:45], v[108:109], v[10:11]
    v_exp_f32 v110, v110
    v_exp_f32 v111, v111
    s_nop 0
    v_pk_add_f32 v[110:111], v[110:111], 1.0 op_sel_hi:[1,0]
    v_rcp_f32 v110, v110
    v_rcp_f32 v111, v111
    s_nop 0
    v_pk_fma_f32 v[10:11], v[46:47], v[110:111], v[10:11]
    s_sub_u32 s41, s41, 1
    s_cmp_eq_u32 s41, 0
    v_cvt_f64_f32 v[112:113], v10
    v_cvt_f64_f32 v[114:115], v11
    ds_add_f64 v24, v[112:113] offset:256
    ds_add_f64 v24, v[114:115] offset:512
    s_cbranch_scc0 L_slow
    s_branch L_mdone
.section .rodata,"a"
.p2align 6
.amdhsa_kernel gather_scatter__edge_featured_mpnn_egc__graph_kernel
  .amdhsa_next_free_vgpr 128
  .amdhsa_next_free_sgpr 96
  .amdhsa_accum_offset 128
  .amdhsa_group_segment_fixed_size 0
  .amdhsa_kernarg_size 80
  .amdhsa_user_sgpr_count 2
  .amdhsa_user_sgpr_kernarg_segment_ptr 1
  .amdhsa_system_sgpr_workgroup_id_x 1
.end_amdhsa_kernel
```
